```python
import torch

def _softmax(x, axis=-1):
    return torch.softmax(x, dim=axis)
def _gelu(x):
    return torch.nn.functional.gelu(x, approximate="tanh")
def _silu(x):
    return torch.nn.functional.silu(x)
def _sigmoid(x):
    return torch.sigmoid(x)
def _layernorm(x, axis=-1, eps=1e-5):
    m = x.mean(dim=axis, keepdim=True)
    v = x.var(dim=axis, keepdim=True, unbiased=False)
    return (x - m) / torch.sqrt(v + eps)
def _scatter_add(tgt, idx, src, axis=0):
    return tgt.clone().index_add_(axis, idx, src)
def _segment_sum(src, seg, n):
    out = torch.zeros((n,) + src.shape[1:], dtype=src.dtype)
    return out.index_add_(0, seg, src)
def _pad(x, pw):
    flat = tuple(v for pair in reversed(pw) for v in pair)
    return torch.nn.functional.pad(x, flat)

kernel_name = 'standalone__spectral_conv_chebnet__graph'

def setup_inputs():

    _w = (lambda a: (lambda t: t.to(torch.bfloat16) if t.is_floating_point() else t)(torch.as_tensor(a)))
    N, deg, D, K = 50000, 16, 64, 3
    E = N * deg
    src = (lambda lo, hi, *s: torch.randint(lo, hi, s))(0, N, E).to(torch.int64)
    dst = (lambda lo, hi, *s: torch.randint(lo, hi, s))(0, N, E).to(torch.int64)
    deg_cnt = torch.bincount(dst, minlength=N).to(float) + 1.0
    dis = (1.0 / (lambda _x: torch.sqrt(torch.as_tensor(_x)))(deg_cnt)).to(float)
    ew = -(dis[src] * dis[dst])
    return {
        "x": _w((lambda *s: torch.randn(*s, dtype=torch.bfloat16) * 0.05)(N, D)),
        "src": _w(src),
        "dst": _w(dst),
        "ew": _w(ew),
        "w": _w((lambda *s: torch.randn(*s, dtype=torch.bfloat16) * 0.05)(K, D, D) * 0.2),
    }

def reference(x, src, dst, ew, w):
    N, K = x.shape[0], w.shape[0]
    Ts = [x]
    if K > 1:
        Ts.append(_segment_sum(ew[:, None] * x[src], dst, N))
    for k in range(2, K):
        Tk = 2.0 * _segment_sum(ew[:, None] * Ts[-1][src], dst, N) - Ts[-2]
        Ts.append(Tk)
    T = torch.stack(Ts, 0)
    return torch.einsum('knd,kde->ne', T, w)
```

```asm
; @launch kernel=part_kernel grid=(206,1,1) block=(1024,1,1) lds=36864
; @launch kernel=main_kernel grid=(250,1,1) block=(832,1,1) lds=141568
.amdgcn_target "amdgcn-amd-amdhsa--gfx950"
.text
.globl part_kernel
.p2align 8
.type part_kernel,@function
part_kernel:
    s_cmp_ge_u32 s2, 196
    s_cbranch_scc1 K1_XTRA
    s_load_dwordx4 s[4:7], s[0:1], 8
    s_load_dwordx2 s[8:9], s[0:1], 24
    s_load_dwordx2 s[12:13], s[0:1], 56
    s_getpc_b64 s[46:47]
    v_and_b32 v32, 31, v0
    v_lshlrev_b32 v32, 6, v32
    global_load_dword v33, v32, s[46:47]
    v_lshlrev_b32 v1, 2, v0
    s_lshl_b32 s14, s2, 12
    v_lshl_add_u32 v3, v0, 2, s14
    s_mov_b32 s15, 800000
    v_cmp_gt_u32 vcc, s15, v3
    v_lshlrev_b32 v34, 2, v3
    v_lshlrev_b32 v35, 1, v3
    v_mov_b32 v2, 0
    ds_write_b32 v1, v2
    s_mov_b64 s[32:33], vcc
    s_and_saveexec_b64 s[38:39], vcc
    s_waitcnt lgkmcnt(0)
    s_cbranch_execz K1_NOLD
    global_load_dwordx4 v[4:7], v34, s[6:7] offset:0
K1_NOLD:
    s_mov_b32 s28, s12
    s_mov_b32 s29, s13
    s_mov_b32 s30, 0x10000000
    s_mov_b32 s31, 0x00020000
    s_mov_b32 s34, 83887
    s_mov_b32 s35, 0xffffff38
    s_mov_b32 s36, 0xffff0000
    v_mov_b32 v2, 1
    s_barrier
    s_waitcnt vmcnt(0)
    s_cbranch_execz K1_NOLD2
    global_load_dwordx4 v[8:11], v34, s[4:5] offset:0
    global_load_dwordx2 v[12:13], v35, s[8:9]
K1_NOLD2:
    v_mul_u32_u24 v14, s34, v4
    v_lshrrev_b32 v14, 24, v14
    v_mad_i32_i24 v23, v14, s35, v4
    v_and_b32 v3, 7, v14
    v_lshrrev_b32 v14, 3, v14
    v_lshlrev_b32 v14, 2, v14
    v_lshl_or_b32 v14, v3, 7, v14
    ds_add_rtn_u32 v18, v14, v2
    v_mul_u32_u24 v15, s34, v5
    v_lshrrev_b32 v15, 24, v15
    v_mad_i32_i24 v25, v15, s35, v5
    v_and_b32 v3, 7, v15
    v_lshrrev_b32 v15, 3, v15
    v_lshlrev_b32 v15, 2, v15
    v_lshl_or_b32 v15, v3, 7, v15
    ds_add_rtn_u32 v19, v15, v2
    v_mul_u32_u24 v16, s34, v6
    v_lshrrev_b32 v16, 24, v16
    v_mad_i32_i24 v27, v16, s35, v6
    v_and_b32 v3, 7, v16
    v_lshrrev_b32 v16, 3, v16
    v_lshlrev_b32 v16, 2, v16
    v_lshl_or_b32 v16, v3, 7, v16
    ds_add_rtn_u32 v20, v16, v2
    v_mul_u32_u24 v17, s34, v7
    v_lshrrev_b32 v17, 24, v17
    v_mad_i32_i24 v29, v17, s35, v7
    v_and_b32 v3, 7, v17
    v_lshrrev_b32 v17, 3, v17
    v_lshlrev_b32 v17, 2, v17
    v_lshl_or_b32 v17, v3, 7, v17
    ds_add_rtn_u32 v21, v17, v2
    s_mov_b64 exec, -1
    s_waitcnt lgkmcnt(0)
    s_barrier
    v_cmp_gt_u32 vcc, 64, v0
    s_cbranch_vccz K1_SCAN_DONE
    v_lshlrev_b32 v32, 4, v0
    ds_read_b128 v[36:39], v32
    s_waitcnt lgkmcnt(0)
    v_add_u32 v41, v36, v37
    v_add_u32 v42, v41, v38
    v_add_u32 v43, v42, v39
    v_mov_b32 v40, v43
    s_nop 1
    v_add_u32_dpp v40, v40, v40 row_shr:1 row_mask:0xf bank_mask:0xf bound_ctrl:0
    s_nop 1
    v_add_u32_dpp v40, v40, v40 row_shr:2 row_mask:0xf bank_mask:0xf bound_ctrl:0
    s_nop 1
    v_add_u32_dpp v40, v40, v40 row_shr:4 row_mask:0xf bank_mask:0xf bound_ctrl:0
    s_nop 1
    v_add_u32_dpp v40, v40, v40 row_shr:8 row_mask:0xf bank_mask:0xf bound_ctrl:0
    s_nop 1
    v_add_u32_dpp v40, v40, v40 row_bcast:15 row_mask:0xa bank_mask:0xf
    s_nop 1
    v_add_u32_dpp v40, v40, v40 row_bcast:31 row_mask:0xc bank_mask:0xf
    v_sub_u32 v44, v40, v43
    v_add_u32 v45, v44, v36
    v_add_u32 v46, v44, v41
    v_add_u32 v47, v44, v42
    ds_write_b128 v32, v[44:47] offset:1024
    v_lshl_or_b32 v48, v36, 16, v44
    v_lshl_or_b32 v49, v37, 16, v45
    v_lshl_or_b32 v50, v38, 16, v46
    v_lshl_or_b32 v51, v39, 16, v47
    s_lshl_b32 s37, s2, 10
    s_add_u32 s37, s37, 0x800000
    buffer_store_dwordx4 v[48:51], v32, s[28:31], s37 offen sc1
    s_waitcnt lgkmcnt(0)
K1_SCAN_DONE:
    s_barrier
    s_mov_b64 exec, s[32:33]
    ds_read_b32 v14, v14 offset:1024
    ds_read_b32 v15, v15 offset:1024
    ds_read_b32 v16, v16 offset:1024
    ds_read_b32 v17, v17 offset:1024
    s_waitcnt vmcnt(1)
    v_cmp_gt_u32 vcc, 64, v0
    s_cbranch_vccnz K1_W0
    s_waitcnt vmcnt(0)
K1_W0:
    s_movk_i32 s37, 96
    v_mul_u32_u24 v3, s34, v8
    v_lshrrev_b32 v3, 24, v3
    v_mad_i32_i24 v3, v3, s35, v8
    v_cmp_le_u32 s[48:49], s37, v3
    v_mul_u32_u24 v3, s34, v9
    v_lshrrev_b32 v3, 24, v3
    v_mad_i32_i24 v3, v3, s35, v9
    v_cmp_le_u32 s[50:51], s37, v3
    v_mul_u32_u24 v3, s34, v10
    v_lshrrev_b32 v3, 24, v3
    v_mad_i32_i24 v3, v3, s35, v10
    v_cmp_le_u32 s[52:53], s37, v3
    v_mul_u32_u24 v3, s34, v11
    v_lshrrev_b32 v3, 24, v3
    v_mad_i32_i24 v3, v3, s35, v11
    v_cmp_le_u32 s[54:55], s37, v3
    v_lshl_or_b32 v22, v12, 16, v8
    v_and_or_b32 v24, v12, s36, v9
    v_lshl_or_b32 v26, v13, 16, v10
    v_and_or_b32 v28, v13, s36, v11
    v_addc_co_u32 v23, vcc, v23, v23, s[48:49]
    v_addc_co_u32 v25, vcc, v25, v25, s[50:51]
    v_addc_co_u32 v27, vcc, v27, v27, s[52:53]
    v_addc_co_u32 v29, vcc, v29, v29, s[54:55]
    s_waitcnt lgkmcnt(0)
    v_add_lshl_u32 v14, v14, v18, 3
    ds_write_b64 v14, v[22:23] offset:4096
    v_add_lshl_u32 v15, v15, v19, 3
    ds_write_b64 v15, v[24:25] offset:4096
    v_add_lshl_u32 v16, v16, v20, 3
    ds_write_b64 v16, v[26:27] offset:4096
    v_add_lshl_u32 v17, v17, v21, 3
    ds_write_b64 v17, v[28:29] offset:4096
    s_mov_b64 exec, -1
    s_waitcnt lgkmcnt(0)
    s_barrier
    v_lshlrev_b32 v1, 4, v0
    ds_read_b128 v[4:7], v1 offset:4096
    ds_read_b128 v[8:11], v1 offset:20480
    s_lshl_b32 s37, s2, 15
    s_waitcnt lgkmcnt(1)
    buffer_store_dwordx4 v[4:7], v1, s[28:31], s37 offen sc1
    s_add_u32 s37, s37, 16384
    s_waitcnt lgkmcnt(0)
    buffer_store_dwordx4 v[8:11], v1, s[28:31], s37 offen sc1
    s_add_u32 s37, s37, 16384
    s_endpgm
K1_XTRA:
    s_cmp_gt_u32 s2, 197
    s_cbranch_scc1 K1_CPF
    s_load_dwordx2 s[10:11], s[0:1], 32
    s_load_dwordx2 s[12:13], s[0:1], 56
    s_sub_u32 s36, s2, 196
    s_mul_i32 s36, s36, 768
    v_cmp_gt_u32 vcc, 768, v0
    s_and_saveexec_b64 s[40:41], vcc
    s_cbranch_execz K1_ZBAR
    v_add_u32 v1, s36, v0
    v_lshrrev_b32 v2, 6, v1
    v_and_b32 v3, 3, v2
    v_lshrrev_b32 v4, 2, v2
    v_and_b32 v5, 15, v1
    v_bfe_u32 v6, v1, 4, 2
    v_lshrrev_b32 v7, 2, v5
    v_lshlrev_b32 v7, 4, v7
    v_lshl_add_u32 v7, v3, 2, v7
    v_and_b32 v8, 3, v5
    v_add_u32 v7, v7, v8
    v_readfirstlane_b32 s38, v4
    v_lshlrev_b32 v9, 12, v4
    s_waitcnt lgkmcnt(0)
    s_mov_b32 s16, s10
    s_mov_b32 s17, s11
    s_mov_b32 s18, 0x6000
    s_mov_b32 s19, 0x00020000
    s_mov_b32 s28, s12
    s_mov_b32 s29, s13
    s_mov_b32 s30, 0x10000000
    s_mov_b32 s31, 0x00020000
    s_mov_b32 s37, 0x900000
    s_lshr_b32 s38, s38, 1
    s_cmp_eq_u32 s38, 1
    s_cbranch_scc1 K2_WP
    v_lshl_add_u32 v9, v6, 10, v9
    v_lshl_add_u32 v9, v7, 1, v9
    buffer_load_ushort v10, v9, s[16:19], 0 offen offset:0
    buffer_load_ushort v11, v9, s[16:19], 0 offen offset:128
    buffer_load_ushort v12, v9, s[16:19], 0 offen offset:256
    buffer_load_ushort v13, v9, s[16:19], 0 offen offset:384
    buffer_load_ushort v14, v9, s[16:19], 0 offen offset:512
    buffer_load_ushort v15, v9, s[16:19], 0 offen offset:640
    buffer_load_ushort v16, v9, s[16:19], 0 offen offset:768
    buffer_load_ushort v17, v9, s[16:19], 0 offen offset:896
    s_branch K2_WQ
K2_WP:
    v_lshl_add_u32 v9, v6, 7, v9
    v_lshl_add_u32 v9, v7, 1, v9
    buffer_load_ushort v10, v9, s[16:19], 0 offen offset:0
    buffer_load_ushort v11, v9, s[16:19], 0 offen offset:1024
    buffer_load_ushort v12, v9, s[16:19], 0 offen offset:2048
    buffer_load_ushort v13, v9, s[16:19], 0 offen offset:3072
    buffer_load_ushort v14, v9, s[16:19], 0 offen offset:512
    buffer_load_ushort v15, v9, s[16:19], 0 offen offset:1536
    buffer_load_ushort v16, v9, s[16:19], 0 offen offset:2560
    buffer_load_ushort v17, v9, s[16:19], 0 offen offset:3584
K2_WQ:
    s_waitcnt vmcnt(0)
    v_lshl_or_b32 v20, v11, 16, v10
    v_lshl_or_b32 v21, v13, 16, v12
    v_lshl_or_b32 v22, v15, 16, v14
    v_lshl_or_b32 v23, v17, 16, v16
    v_lshlrev_b32 v1, 4, v1
    buffer_store_dwordx4 v[20:23], v1, s[28:31], s37 offen
    s_endpgm
K1_ZBAR:
    s_mov_b64 exec, -1
    v_and_b32 v1, 255, v0
    v_lshlrev_b32 v1, 4, v1
    v_mov_b32 v4, 0
    v_mov_b32 v5, 0
    v_mov_b32 v6, 0
    v_mov_b32 v7, 0
    s_waitcnt lgkmcnt(0)
    s_mov_b32 s28, s12
    s_mov_b32 s29, s13
    s_mov_b32 s30, 0x10000000
    s_mov_b32 s31, 0x00020000
    s_mov_b32 s37, 0xa00000
    buffer_store_dwordx4 v[4:7], v1, s[28:31], s37 offen
    s_mov_b32 s37, 0xa01000
    buffer_store_dwordx4 v[4:7], v1, s[28:31], s37 offen
    s_mov_b32 s37, 0xa02000
    buffer_store_dwordx4 v[4:7], v1, s[28:31], s37 offen
    s_mov_b32 s37, 0xa03000
    buffer_store_dwordx4 v[4:7], v1, s[28:31], s37 offen
    s_endpgm
K1_CPF:
    s_cmp_gt_u32 s2, 205
    s_cbranch_scc1 K1_HELP
    s_getpc_b64 s[4:5]
K1_PCREF:
    s_add_u32 s4, s4, main_kernel-K1_PCREF
    s_addc_u32 s5, s5, 0
    v_lshlrev_b32 v1, 6, v0
    s_mov_b32 s6, M_CODE_END-main_kernel
    v_cmp_gt_u32 vcc, s6, v1
    s_and_saveexec_b64 s[8:9], vcc
    s_cbranch_execz K1_END
    global_load_dword v2, v1, s[4:5]
    s_waitcnt vmcnt(0)
    s_endpgm
K1_HELP:
K1_END:
    s_endpgm
.globl main_kernel
.p2align 8
.type main_kernel,@function
main_kernel:
    s_cmp_ge_u32 s2, 250
    s_cbranch_scc1 M_END2
    s_load_dwordx2 s[4:5], s[0:1], 0
    s_load_dwordx4 s[8:11], s[0:1], 40
    s_load_dwordx2 s[12:13], s[0:1], 56
    v_lshrrev_b32 v14, 6, v0
    v_and_b32 v15, 7, v0
    v_readfirstlane_b32 s67, v14
    v_lshlrev_b32 v1, 4, v15
    s_movk_i32 s32, 128
    s_mov_b32 s33, 0xffff0000
    s_mov_b32 s34, 0
    s_mov_b32 s84, 0
    s_mov_b32 s81, 0
    s_mov_b32 s64, 0
    s_mov_b32 s80, 0xffff
    s_mov_b32 s70, 60400
    s_mul_i32 s68, s2, 25600
    s_movk_i32 s71, 272
    s_mov_b32 s38, 0x65472103
    s_mov_b32 s39, 0xc89ab
    s_lshl_b32 s65, s67, 2
    s_lshr_b64 s[38:39], s[38:39], s65
    s_and_b32 s75, s38, 15
    s_lshl_b32 s75, s75, 6
    s_add_u32 s75, s75, 4112
    v_mov_b32 v14, 0
    v_mov_b32 v15, 4096
    ds_write_b32 v15, v14
    v_and_b32 v15, 7, v0
    v_lshlrev_b32 v15, 2, v15
    ds_write_b32 v15, v14 offset:5792
    s_waitcnt lgkmcnt(0)
    s_mov_b32 s20, s12
    s_mov_b32 s21, s13
    s_mov_b32 s22, 0x10000000
    s_mov_b32 s23, 0x00020000
M_ROUND:
    v_lshrrev_b32 v100, 2, v0
    v_lshlrev_b32 v14, 10, v100
    s_and_b32 s65, s2, 7
    s_lshl_b32 s65, s65, 5
    s_lshr_b32 s66, s2, 3
    s_add_u32 s65, s65, s66
    s_lshl_b32 s65, s65, 2
    s_add_u32 s65, s65, 0x800000
    v_mov_b32 v103, 0
    v_cmp_gt_u32 vcc, 784, v0
    s_and_saveexec_b64 s[38:39], vcc
    buffer_load_dword v103, v14, s[20:23], s65 offen
    s_mov_b64 exec, s[38:39]
    s_or_b32 s65, s84, s34
    s_cmp_lg_u32 s65, 0
    s_cbranch_scc1 M_NOSRD
    s_mov_b32 s16, s4
    s_mov_b32 s17, s5
    s_mov_b32 s18, 0x61a800
    s_mov_b32 s19, 0x00020000
    s_mov_b32 s28, s4
    s_mov_b32 s29, s5
    s_mov_b32 s30, 0x61a800
    s_mov_b32 s31, 0x00020000
    s_add_u32 s76, s12, 0x2000000
    s_addc_u32 s77, s13, 0
    s_mov_b32 s78, 0x61a800
    s_mov_b32 s79, 0x00020000
    s_mov_b32 s24, s8
    s_mov_b32 s25, s9
    s_mov_b32 s26, 0x61a800
    s_mov_b32 s27, 0x00020000
    v_lshlrev_b32 v14, 4, v0
    s_mov_b32 s65, 0x900000
    buffer_load_dwordx4 v[16:19], v14, s[20:23], s65 offen
    s_add_u32 s65, s65, 13312
    buffer_load_dwordx4 v[20:23], v14, s[20:23], s65 offen
M_NOSRD:
    v_lshlrev_b32 v14, 2, v0
    v_mov_b32 v15, 0
    v_cmp_gt_u32 vcc, 512, v0
    s_and_saveexec_b64 s[38:39], vcc
    ds_write_b32 v14, v15
    s_mov_b64 exec, s[38:39]
    v_mov_b32 v88, 0xffff
    v_mov_b32 v89, 0xffff
    v_mov_b32 v90, 0xffff
    v_mov_b32 v91, 0xffff
    v_lshlrev_b32 v14, 4, v0
    ds_write_b128 v14, v[88:91] offset:7168
    ds_write_b128 v14, v[88:91] offset:20480
    ds_write_b128 v14, v[88:91] offset:33792
    ds_write_b128 v14, v[88:91] offset:47104
    v_and_b32 v102, 3, v0
    v_lshlrev_b32 v102, 1, v102
    s_mul_i32 s65, s34, 48
    v_add_u32 v102, s65, v102
    v_mov_b32 v104, 1
    s_waitcnt vmcnt(2)
    s_or_b32 s65, s84, s34
    s_cmp_eq_u32 s65, 0
    s_cbranch_scc1 M_DW
    s_waitcnt vmcnt(0)
M_DW:
    v_and_b32 v101, 0xffff, v103
    v_lshrrev_b32 v103, 16, v103
    v_add_u32 v101, v101, v102
    v_lshlrev_b32 v101, 3, v101
    v_lshl_add_u32 v101, v100, 15, v101
    v_sub_u32 v105, v103, v102
    v_cmp_lt_i32 s[40:41], 0, v105
    v_cmp_lt_i32 s[42:43], 1, v105
    v_cmp_lt_i32 s[44:45], 8, v105
    v_cmp_lt_i32 s[46:47], 9, v105
    v_cmp_lt_i32 s[48:49], 16, v105
    v_cmp_lt_i32 s[50:51], 17, v105
    v_cmp_lt_i32 s[52:53], 24, v105
    v_cmp_lt_i32 s[54:55], 25, v105
    v_cmp_lt_i32 s[56:57], 32, v105
    v_cmp_lt_i32 s[58:59], 33, v105
    v_cmp_lt_i32 s[60:61], 40, v105
    v_cmp_lt_i32 s[62:63], 41, v105
    s_mov_b64 exec, s[40:41]
    s_cbranch_execz M_LD_X
    buffer_load_dwordx4 v[64:67], v101, s[20:23], 0 offen offset:0
    s_mov_b64 exec, s[44:45]
    s_cbranch_execz M_LD_X
    buffer_load_dwordx4 v[68:71], v101, s[20:23], 0 offen offset:64
    s_mov_b64 exec, s[48:49]
    s_cbranch_execz M_LD_X
    buffer_load_dwordx4 v[72:75], v101, s[20:23], 0 offen offset:128
    s_mov_b64 exec, s[52:53]
    s_cbranch_execz M_LD_X
    buffer_load_dwordx4 v[76:79], v101, s[20:23], 0 offen offset:192
    s_mov_b64 exec, s[56:57]
    s_cbranch_execz M_LD_X
    buffer_load_dwordx4 v[80:83], v101, s[20:23], 0 offen offset:256
    s_mov_b64 exec, s[60:61]
    s_cbranch_execz M_LD_X
    buffer_load_dwordx4 v[84:87], v101, s[20:23], 0 offen offset:320
M_LD_X:
    s_mov_b64 exec, -1
    s_waitcnt lgkmcnt(0)
    s_barrier
    v_cmp_lt_u32 vcc, 48, v103
    s_cbranch_vccz M_NOMAX
    v_mov_b32 v15, 4096
    ds_max_u32 v15, v103
M_NOMAX:
    s_waitcnt vmcnt(0)
    s_or_b32 s65, s84, s34
    s_cmp_lg_u32 s65, 0
    s_cbranch_scc1 M_NOW
    s_mov_b32 m0, 6912
    s_mov_b64 exec, s[40:41]
    v_cmp_gt_u32 vcc, 192, v65
    v_mad_u32_u16 v126, v64, s32, 0
    s_and_b64 exec, exec, vcc
    s_cbranch_execz M_TP0
    buffer_load_dword v126, s[16:19], 0 offen lds
M_TP0:
    s_mov_b64 exec, -1
    v_lshlrev_b32 v14, 4, v0
    v_add_u32 v14, 60416, v14
    ds_write_b128 v14, v[16:19]
    v_cmp_gt_u32 vcc, 704, v0
    s_and_saveexec_b64 s[38:39], vcc
    ds_write_b128 v14, v[20:23] offset:13312
    s_mov_b64 exec, s[38:39]
M_NOW:
    s_mov_b64 exec, s[40:41]
    v_lshlrev_b32 v65, 2, v65
    ds_add_rtn_u32 v88, v65, v104
    s_mov_b64 exec, s[42:43]
    v_lshlrev_b32 v67, 2, v67
    ds_add_rtn_u32 v89, v67, v104
    s_mov_b64 exec, s[44:45]
    v_lshlrev_b32 v69, 2, v69
    ds_add_rtn_u32 v90, v69, v104
    s_mov_b64 exec, s[46:47]
    v_lshlrev_b32 v71, 2, v71
    ds_add_rtn_u32 v91, v71, v104
    s_mov_b64 exec, s[48:49]
    s_cbranch_execz M_AT_X
    v_lshlrev_b32 v73, 2, v73
    ds_add_rtn_u32 v92, v73, v104
    s_mov_b64 exec, s[50:51]
    v_lshlrev_b32 v75, 2, v75
    ds_add_rtn_u32 v93, v75, v104
    s_mov_b64 exec, s[52:53]
    s_cbranch_execz M_AT_X
    v_lshlrev_b32 v77, 2, v77
    ds_add_rtn_u32 v94, v77, v104
    s_mov_b64 exec, s[54:55]
    v_lshlrev_b32 v79, 2, v79
    ds_add_rtn_u32 v95, v79, v104
    s_mov_b64 exec, s[56:57]
    s_cbranch_execz M_AT_X
    v_lshlrev_b32 v81, 2, v81
    ds_add_rtn_u32 v96, v81, v104
    s_mov_b64 exec, s[58:59]
    v_lshlrev_b32 v83, 2, v83
    ds_add_rtn_u32 v97, v83, v104
    s_mov_b64 exec, s[60:61]
    s_cbranch_execz M_AT_X
    v_lshlrev_b32 v85, 2, v85
    ds_add_rtn_u32 v98, v85, v104
    s_mov_b64 exec, s[62:63]
    v_lshlrev_b32 v87, 2, v87
    ds_add_rtn_u32 v99, v87, v104
M_AT_X:
    s_mov_b64 exec, -1
    s_waitcnt lgkmcnt(0)
    s_barrier
    s_cmp_lg_u32 s67, 12
    s_cbranch_scc1 M_SCAN_DONE
    v_and_b32 v106, 63, v0
    v_lshlrev_b32 v14, 5, v106
    ds_read_b128 v[108:111], v14
    ds_read_b128 v[112:115], v14 offset:16
    v_mov_b32 v60, 0
    v_mov_b32 v61, 0
    v_lshlrev_b32 v107, 3, v106
    ds_write_b64 v107, v[60:61] offset:5888
    v_cmp_gt_u32 vcc, 50, v106
    s_mov_b64 s[36:37], vcc
    v_cmp_gt_u32 vcc, 24, v106
    v_mov_b32 v126, 127
    v_mov_b32 v15, 63
    v_cndmask_b32 v126, v126, v15, vcc
    s_waitcnt lgkmcnt(1)
    s_mov_b64 exec, s[36:37]
    v_add_u32 v15, 3, v108
    v_add_u32 v59, 3, v109
    v_lshrrev_b32 v15, 2, v15
    v_lshrrev_b32 v59, 2, v59
    v_min_u32 v15, 7, v15
    v_min_u32 v59, 7, v59
    v_lshl_add_u32 v15, v15, 3, v59
    v_sub_u32 v15, v126, v15
    v_lshlrev_b32 v116, 2, v15
    ds_add_rtn_u32 v120, v116, v104 offset:5888
    v_add_u32 v15, 3, v110
    v_add_u32 v59, 3, v111
    v_lshrrev_b32 v15, 2, v15
    v_lshrrev_b32 v59, 2, v59
    v_min_u32 v15, 7, v15
    v_min_u32 v59, 7, v59
    v_lshl_add_u32 v15, v15, 3, v59
    v_sub_u32 v15, v126, v15
    v_lshlrev_b32 v117, 2, v15
    ds_add_rtn_u32 v121, v117, v104 offset:5888
    v_add_u32 v15, 3, v112
    v_add_u32 v59, 3, v113
    v_lshrrev_b32 v15, 2, v15
    v_lshrrev_b32 v59, 2, v59
    v_min_u32 v15, 7, v15
    v_min_u32 v59, 7, v59
    v_lshl_add_u32 v15, v15, 3, v59
    v_sub_u32 v15, v126, v15
    v_lshlrev_b32 v118, 2, v15
    ds_add_rtn_u32 v122, v118, v104 offset:5888
    v_add_u32 v15, 3, v114
    v_add_u32 v59, 3, v115
    v_lshrrev_b32 v15, 2, v15
    v_lshrrev_b32 v59, 2, v59
    v_min_u32 v15, 7, v15
    v_min_u32 v59, 7, v59
    v_lshl_add_u32 v15, v15, 3, v59
    v_sub_u32 v15, v126, v15
    v_lshlrev_b32 v119, 2, v15
    ds_add_rtn_u32 v123, v119, v104 offset:5888
    s_mov_b64 exec, -1
    v_add_u32 v108, 3, v108
    v_and_b32 v108, -4, v108
    v_add_u32 v109, 3, v109
    v_and_b32 v109, -4, v109
    v_add_u32 v110, 3, v110
    v_and_b32 v110, -4, v110
    v_add_u32 v111, 3, v111
    v_and_b32 v111, -4, v111
    v_add_u32 v112, 3, v112
    v_and_b32 v112, -4, v112
    v_add_u32 v113, 3, v113
    v_and_b32 v113, -4, v113
    v_add_u32 v114, 3, v114
    v_and_b32 v114, -4, v114
    v_add_u32 v115, 3, v115
    v_and_b32 v115, -4, v115
    v_mov_b32 v48, 0
    v_mov_b32 v49, v108
    v_add_u32 v50, v49, v109
    v_add_u32 v51, v50, v110
    v_add_u32 v52, v51, v111
    v_add_u32 v53, v52, v112
    v_add_u32 v54, v53, v113
    v_add_u32 v55, v54, v114
    v_add_u32 v56, v55, v115
    v_mov_b32 v57, v56
    s_nop 1
    v_add_u32_dpp v57, v57, v57 row_shr:1 row_mask:0xf bank_mask:0xf bound_ctrl:0
    s_nop 1
    v_add_u32_dpp v57, v57, v57 row_shr:2 row_mask:0xf bank_mask:0xf bound_ctrl:0
    s_nop 1
    v_add_u32_dpp v57, v57, v57 row_shr:4 row_mask:0xf bank_mask:0xf bound_ctrl:0
    s_nop 1
    v_add_u32_dpp v57, v57, v57 row_shr:8 row_mask:0xf bank_mask:0xf bound_ctrl:0
    s_nop 1
    v_add_u32_dpp v57, v57, v57 row_bcast:15 row_mask:0xa bank_mask:0xf
    s_nop 1
    v_add_u32_dpp v57, v57, v57 row_bcast:31 row_mask:0xc bank_mask:0xf
    v_sub_u32 v58, v57, v56
    v_add_u32 v48, v58, v48
    v_add_u32 v49, v58, v49
    v_add_u32 v50, v58, v50
    v_add_u32 v51, v58, v51
    v_add_u32 v52, v58, v52
    v_add_u32 v53, v58, v53
    v_add_u32 v54, v58, v54
    v_add_u32 v55, v58, v55
    ds_write_b128 v14, v[48:51] offset:2048
    ds_write_b128 v14, v[52:55] offset:2064
    s_waitcnt lgkmcnt(0)
M_SCAN_DONE:
    s_barrier
    s_mov_b64 exec, s[40:41]
    ds_read_b32 v65, v65 offset:2048
    s_mov_b64 exec, s[42:43]
    ds_read_b32 v67, v67 offset:2048
    s_mov_b64 exec, s[44:45]
    ds_read_b32 v69, v69 offset:2048
    s_mov_b64 exec, s[46:47]
    ds_read_b32 v71, v71 offset:2048
    s_mov_b64 exec, s[48:49]
    s_cbranch_execz M_RD_X
    ds_read_b32 v73, v73 offset:2048
    s_mov_b64 exec, s[50:51]
    ds_read_b32 v75, v75 offset:2048
    s_mov_b64 exec, s[52:53]
    s_cbranch_execz M_RD_X
    ds_read_b32 v77, v77 offset:2048
    s_mov_b64 exec, s[54:55]
    ds_read_b32 v79, v79 offset:2048
    s_mov_b64 exec, s[56:57]
    s_cbranch_execz M_RD_X
    ds_read_b32 v81, v81 offset:2048
    s_mov_b64 exec, s[58:59]
    ds_read_b32 v83, v83 offset:2048
    s_mov_b64 exec, s[60:61]
    s_cbranch_execz M_RD_X
    ds_read_b32 v85, v85 offset:2048
    s_mov_b64 exec, s[62:63]
    ds_read_b32 v87, v87 offset:2048
M_RD_X:
    s_mov_b64 exec, -1
    s_waitcnt lgkmcnt(0)
    s_mov_b64 exec, s[40:41]
    v_add_lshl_u32 v65, v65, v88, 2
    ds_write_b32 v65, v64 offset:7168
    s_mov_b64 exec, s[42:43]
    v_add_lshl_u32 v67, v67, v89, 2
    ds_write_b32 v67, v66 offset:7168
    s_mov_b64 exec, s[44:45]
    v_add_lshl_u32 v69, v69, v90, 2
    ds_write_b32 v69, v68 offset:7168
    s_mov_b64 exec, s[46:47]
    v_add_lshl_u32 v71, v71, v91, 2
    ds_write_b32 v71, v70 offset:7168
    s_mov_b64 exec, s[48:49]
    s_cbranch_execz M_WR_X
    v_add_lshl_u32 v73, v73, v92, 2
    ds_write_b32 v73, v72 offset:7168
    s_mov_b64 exec, s[50:51]
    v_add_lshl_u32 v75, v75, v93, 2
    ds_write_b32 v75, v74 offset:7168
    s_mov_b64 exec, s[52:53]
    s_cbranch_execz M_WR_X
    v_add_lshl_u32 v77, v77, v94, 2
    ds_write_b32 v77, v76 offset:7168
    s_mov_b64 exec, s[54:55]
    v_add_lshl_u32 v79, v79, v95, 2
    ds_write_b32 v79, v78 offset:7168
    s_mov_b64 exec, s[56:57]
    s_cbranch_execz M_WR_X
    v_add_lshl_u32 v81, v81, v96, 2
    ds_write_b32 v81, v80 offset:7168
    s_mov_b64 exec, s[58:59]
    v_add_lshl_u32 v83, v83, v97, 2
    ds_write_b32 v83, v82 offset:7168
    s_mov_b64 exec, s[60:61]
    s_cbranch_execz M_WR_X
    v_add_lshl_u32 v85, v85, v98, 2
    ds_write_b32 v85, v84 offset:7168
    s_mov_b64 exec, s[62:63]
    v_add_lshl_u32 v87, v87, v99, 2
    ds_write_b32 v87, v86 offset:7168
M_WR_X:
    s_mov_b64 exec, -1
    s_cmp_lg_u32 s67, 12
    s_cbranch_scc1 M_DESC_DONE
    s_or_b32 s65, s84, s34
    s_cmp_lg_u32 s65, 0
    s_cbranch_scc1 M_DESC_REDO
    s_mov_b64 s[38:39], s[36:37]
    v_lshrrev_b32 v108, 2, v108
    v_lshrrev_b32 v109, 2, v109
    v_lshrrev_b32 v110, 2, v110
    v_lshrrev_b32 v111, 2, v111
    v_lshrrev_b32 v112, 2, v112
    v_lshrrev_b32 v113, 2, v113
    v_lshrrev_b32 v114, 2, v114
    v_lshrrev_b32 v115, 2, v115
    ds_read_b64 v[124:125], v107 offset:5888
    s_waitcnt lgkmcnt(0)
    v_add_u32 v125, v124, v125
    v_mov_b32 v62, v125
    s_nop 1
    v_add_u32_dpp v62, v62, v62 row_shr:1 row_mask:0xf bank_mask:0xf bound_ctrl:0
    s_nop 1
    v_add_u32_dpp v62, v62, v62 row_shr:2 row_mask:0xf bank_mask:0xf bound_ctrl:0
    s_nop 1
    v_add_u32_dpp v62, v62, v62 row_shr:4 row_mask:0xf bank_mask:0xf bound_ctrl:0
    s_nop 1
    v_add_u32_dpp v62, v62, v62 row_shr:8 row_mask:0xf bank_mask:0xf bound_ctrl:0
    s_nop 1
    v_add_u32_dpp v62, v62, v62 row_bcast:15 row_mask:0xa bank_mask:0xf
    s_nop 1
    v_add_u32_dpp v62, v62, v62 row_bcast:31 row_mask:0xc bank_mask:0xf
    v_sub_u32 v62, v62, v125
    v_cmp_lt_u32 vcc, 31, v106
    v_mov_b32 v63, 0
    v_mov_b32 v15, 8
    v_cndmask_b32 v63, v63, v15, vcc
    v_add_u32 v62, v62, v63
    v_add_u32 v63, v62, v124
    ds_write_b64 v107, v[62:63] offset:6400
    s_mov_b64 exec, 0xff
    v_mov_b32 v60, 200
    v_mov_b32 v61, 0
    v_lshlrev_b32 v15, 3, v106
    ds_write_b64 v15, v[60:61] offset:4880
    s_mov_b64 exec, s[38:39]
    s_waitcnt lgkmcnt(0)
    ds_read_b32 v116, v116 offset:6400
    ds_read_b32 v117, v117 offset:6400
    ds_read_b32 v118, v118 offset:6400
    ds_read_b32 v119, v119 offset:6400
    v_lshl_add_u32 v15, v106, 2, 0
    v_lshl_or_b32 v32, v48, 6, v15
    v_lshl_or_b32 v33, v109, 16, v108
    v_lshl_add_u32 v15, v106, 2, 1
    v_lshl_or_b32 v34, v50, 6, v15
    v_lshl_or_b32 v35, v111, 16, v110
    v_lshl_add_u32 v15, v106, 2, 2
    v_lshl_or_b32 v36, v52, 6, v15
    v_lshl_or_b32 v37, v113, 16, v112
    v_lshl_add_u32 v15, v106, 2, 3
    v_lshl_or_b32 v38, v54, 6, v15
    v_lshl_or_b32 v39, v115, 16, v114
    s_waitcnt lgkmcnt(0)
    v_add_lshl_u32 v116, v116, v120, 3
    ds_write_b64 v116, v[32:33] offset:4112
    v_add_lshl_u32 v117, v117, v121, 3
    ds_write_b64 v117, v[34:35] offset:4112
    v_add_lshl_u32 v118, v118, v122, 3
    ds_write_b64 v118, v[36:37] offset:4112
    v_add_lshl_u32 v119, v119, v123, 3
    ds_write_b64 v119, v[38:39] offset:4112
    s_mov_b64 exec, -1
    s_branch M_DESC_DONE
M_DESC_REDO:
    v_cmp_gt_u32 vcc, 52, v106
    s_mov_b64 exec, vcc
    ds_read_b128 v[108:111], v14 offset:4112
    ds_read_b128 v[112:115], v14 offset:4128
    s_waitcnt lgkmcnt(0)
    v_and_b32 v108, 255, v108
    v_lshlrev_b32 v15, 3, v108
    v_add_u32 v15, 2048, v15
    ds_read2_b32 v[48:49], v15 offset0:0 offset1:1
    ds_read_b32 v50, v15 offset:8
    v_and_b32 v110, 255, v110
    v_lshlrev_b32 v15, 3, v110
    v_add_u32 v15, 2048, v15
    ds_read2_b32 v[52:53], v15 offset0:0 offset1:1
    ds_read_b32 v54, v15 offset:8
    v_and_b32 v112, 255, v112
    v_lshlrev_b32 v15, 3, v112
    v_add_u32 v15, 2048, v15
    ds_read2_b32 v[56:57], v15 offset0:0 offset1:1
    ds_read_b32 v58, v15 offset:8
    v_and_b32 v114, 255, v114
    v_lshlrev_b32 v15, 3, v114
    v_add_u32 v15, 2048, v15
    ds_read2_b32 v[60:61], v15 offset0:0 offset1:1
    ds_read_b32 v62, v15 offset:8
    s_waitcnt lgkmcnt(0)
    v_lshl_or_b32 v108, v48, 6, v108
    v_sub_u32 v15, v49, v48
    v_lshrrev_b32 v15, 2, v15
    v_sub_u32 v109, v50, v49
    v_lshl_or_b32 v109, v109, 14, v15
    v_lshl_or_b32 v110, v52, 6, v110
    v_sub_u32 v15, v53, v52
    v_lshrrev_b32 v15, 2, v15
    v_sub_u32 v111, v54, v53
    v_lshl_or_b32 v111, v111, 14, v15
    v_lshl_or_b32 v112, v56, 6, v112
    v_sub_u32 v15, v57, v56
    v_lshrrev_b32 v15, 2, v15
    v_sub_u32 v113, v58, v57
    v_lshl_or_b32 v113, v113, 14, v15
    v_lshl_or_b32 v114, v60, 6, v114
    v_sub_u32 v15, v61, v60
    v_lshrrev_b32 v15, 2, v15
    v_sub_u32 v115, v62, v61
    v_lshl_or_b32 v115, v115, 14, v15
    ds_write_b128 v14, v[108:111] offset:4112
    ds_write_b128 v14, v[112:115] offset:4128
    s_mov_b64 exec, -1
M_DESC_DONE:
    s_waitcnt lgkmcnt(0)
    s_barrier
M_PHASE_B:
    s_mov_b32 s72, 0
    v_mov_b32 v15, 4096
    ds_read_b32 v6, v15
    v_and_b32 v14, 1, v0
    s_mov_b32 s65, 0x0c0c0302
    s_mov_b32 s66, 0x03020c0c
    v_cmp_eq_u32 vcc, 0, v14
    v_mov_b32 v14, s66
    v_mov_b32 v15, s65
    v_cndmask_b32 v14, v14, v15, vcc
    v_and_b32 v15, 2, v0
    v_cmp_eq_u32 vcc, 0, v15
    v_mov_b32 v15, 0x0c0c0c0c
    s_nop 0
    v_cndmask_b32 v7, v15, v14, vcc
    v_cndmask_b32 v13, v14, v15, vcc
    s_waitcnt lgkmcnt(0)
    v_readfirstlane_b32 s35, v6
M_SEG:
    v_bfe_u32 v15, v0, 3, 3
    v_lshl_add_u32 v14, v15, 3, s75
    ds_read_b64 v[8:9], v14
    ds_read_b64 v[10:11], v14 offset:832
    s_cmp_lg_u32 s84, 0
    s_cbranch_scc1 M_SEG2
    s_setprio 3
    s_movk_i32 s69, 32
    s_waitcnt lgkmcnt(0)
    v_and_b32 v14, 255, v8
    v_and_b32 v15, 255, v10
    v_lshl_or_b32 v12, v15, 16, v14
    s_cmp_eq_u32 s72, 0
    s_cbranch_scc1 M_SEG1A
    s_setprio 2
    v_mov_b32 v8, v10
    v_mov_b32 v9, v11
M_SEG1A:
    v_lshrrev_b32 v2, 8, v8
    v_lshlrev_b32 v2, 4, v2
    v_add_u32 v2, 7168, v2
    v_and_b32 v14, 0xffff, v9
    v_lshrrev_b32 v15, 16, v9
    v_add_u32 v14, v14, v15
    v_lshl_add_u32 v3, v14, 4, v2
    v_add_u32 v4, 16, v2
    v_mov_b32 v5, v3
    s_branch M_GW_OK
M_SEG2:
    s_movk_i32 s69, 16
    s_lshl_b32 s65, s72, 2
    s_add_u32 s65, s65, 5800
    v_mov_b32 v14, s65
    ds_read_b32 v15, v14
    s_waitcnt lgkmcnt(0)
    v_readfirstlane_b32 s66, v15
    v_lshrrev_b32 v2, 8, v8
    v_lshlrev_b32 v2, 4, v2
    v_add_u32 v2, 7168, v2
    v_and_b32 v3, 0xffff, v9
    v_lshl_add_u32 v3, v3, 4, v2
    v_lshrrev_b32 v4, 8, v10
    v_lshlrev_b32 v4, 4, v4
    v_add_u32 v4, 7168, v4
    v_and_b32 v5, 0xffff, v11
    v_lshl_add_u32 v5, v5, 4, v4
    s_setprio 1
    s_cmp_eq_u32 s72, 0
    s_cbranch_scc1 M_SEG2A
    s_setprio 0
    v_mov_b32 v2, v3
    v_lshrrev_b32 v9, 16, v9
    v_lshl_add_u32 v3, v9, 4, v3
    v_mov_b32 v4, v5
    v_lshrrev_b32 v11, 16, v11
    v_lshl_add_u32 v5, v11, 4, v5
M_SEG2A:
    s_cmp_lg_u32 s66, 0
    s_cbranch_scc1 M_GW_OK
    s_cmp_eq_u32 s81, 0
    s_cbranch_scc1 M_RET1
    s_mov_b32 s82, 1
    s_mov_b32 s83, 0
    s_branch M_POSTWORK
M_RET1:
    s_lshl_b32 s65, s72, 2
    s_add_u32 s65, s65, 5800
    v_mov_b32 v14, s65
    v_mov_b32 v15, 1
    v_and_b32 v64, 15, v0
    v_lshlrev_b32 v64, 2, v64
    s_mov_b64 exec, 1
    ds_add_rtn_u32 v15, v14, v15 offset:8
    s_mov_b32 s85, 0
    s_waitcnt lgkmcnt(0)
    v_readfirstlane_b32 s65, v15
    s_cmp_lg_u32 s65, 0
    s_cbranch_scc1 M_GW_SPIN
    s_lshl_b32 s66, s72, 13
    s_add_u32 s66, s66, 0xa00800
    s_and_b32 s65, s2, 31
    s_lshl_b32 s65, s65, 7
    s_add_u32 s66, s66, s65
M_POLL:
    s_mov_b32 s65, 0
    s_atomic_add s65, s[12:13], s66 glc
    s_waitcnt lgkmcnt(0)
    s_add_u32 s85, s85, 1
    s_cmp_ge_u32 s65, 16
    s_cbranch_scc1 M_POLLED
    s_cmp_ge_u32 s85, 6000000
    s_cbranch_scc1 M_POLLED
    s_sleep 2
    s_branch M_POLL
M_POLLED:
    v_mov_b32 v15, 1
    ds_write_b32 v14, v15
    s_branch M_GW_DONE
M_GW_SPIN:
    s_sleep 1
    ds_read_b32 v15, v14
    s_waitcnt lgkmcnt(0)
    v_readfirstlane_b32 s65, v15
    s_cmp_eq_u32 s65, 0
    s_cbranch_scc1 M_GW_SPIN
M_GW_DONE:
    s_mov_b64 exec, -1
    s_waitcnt lgkmcnt(0)
M_GW_OK:
    v_cmp_lt_u32 vcc, v2, v3
    v_mov_b32 v6, s70
    s_bitset0_b32 s64, 0
    v_cndmask_b32 v6, v6, v2, vcc
    s_cmp_eq_u64 vcc, 0
    s_cselect_b32 s85, 1, 0
    s_or_b32 s64, s64, s85
    v_add_u32 v2, s69, v2
    ds_read_b128 v[48:51], v6
    v_cmp_lt_u32 s[36:37], v4, v5
    v_mov_b32 v6, s70
    s_bitset0_b32 s64, 1
    v_cndmask_b32 v6, v6, v4, s[36:37]
    s_cmp_eq_u64 s[36:37], 0
    s_cselect_b32 s85, 2, 0
    s_or_b32 s64, s64, s85
    v_add_u32 v4, s69, v4
    ds_read_b128 v[52:55], v6
    s_or_b64 s[38:39], vcc, s[36:37]
    s_cselect_b32 s66, 1, 0
    v_cmp_lt_u32 vcc, v2, v3
    v_mov_b32 v6, s70
    s_bitset0_b32 s64, 2
    v_cndmask_b32 v6, v6, v2, vcc
    s_cmp_eq_u64 vcc, 0
    s_cselect_b32 s85, 4, 0
    s_or_b32 s64, s64, s85
    v_add_u32 v2, s69, v2
    ds_read_b128 v[56:59], v6
    v_cmp_lt_u32 s[36:37], v4, v5
    v_mov_b32 v6, s70
    s_bitset0_b32 s64, 3
    v_cndmask_b32 v6, v6, v4, s[36:37]
    s_cmp_eq_u64 s[36:37], 0
    s_cselect_b32 s85, 8, 0
    s_or_b32 s64, s64, s85
    v_add_u32 v4, s69, v4
    ds_read_b128 v[60:63], v6
    s_or_b64 s[38:39], vcc, s[36:37]
    s_cselect_b32 s65, 2, 0
    s_or_b32 s74, s65, s66
    s_bitcmp1_b32 s74, 0
    s_cbranch_scc0 M_PRO_DONE
    s_waitcnt lgkmcnt(3)
    s_bitcmp1_b32 s64, 0
    s_cbranch_scc1 M_CH1
    v_mad_u32_u16 v64, v48, s32, v1
    v_mad_u32_u16 v68, v49, s32, v1
    v_mad_u32_u16 v72, v50, s32, v1
    v_mad_u32_u16 v76, v51, s32, v1
    buffer_load_dwordx4 v[64:67], v64, s[16:19], 0 offen sc1
    buffer_load_dwordx4 v[68:71], v68, s[16:19], 0 offen sc1
    buffer_load_dwordx4 v[72:75], v72, s[16:19], 0 offen sc1
    buffer_load_dwordx4 v[76:79], v76, s[16:19], 0 offen sc1
M_CR1:
    s_waitcnt lgkmcnt(2)
    s_bitcmp1_b32 s64, 1
    s_cbranch_scc1 M_CH2
    v_mad_u32_u16 v80, v52, s32, v1
    v_mad_u32_u16 v84, v53, s32, v1
    v_mad_u32_u16 v88, v54, s32, v1
    v_mad_u32_u16 v92, v55, s32, v1
    buffer_load_dwordx4 v[80:83], v80, s[16:19], 0 offen sc1
    buffer_load_dwordx4 v[84:87], v84, s[16:19], 0 offen sc1
    buffer_load_dwordx4 v[88:91], v88, s[16:19], 0 offen sc1
    buffer_load_dwordx4 v[92:95], v92, s[16:19], 0 offen sc1
M_CR2:
    s_bitcmp1_b32 s74, 1
    s_cbranch_scc0 M_PRO_DONE
    s_waitcnt lgkmcnt(1)
    s_bitcmp1_b32 s64, 2
    s_cbranch_scc1 M_CH3
    v_mad_u32_u16 v96, v56, s32, v1
    v_mad_u32_u16 v100, v57, s32, v1
    v_mad_u32_u16 v104, v58, s32, v1
    v_mad_u32_u16 v108, v59, s32, v1
    buffer_load_dwordx4 v[96:99], v96, s[16:19], 0 offen sc1
    buffer_load_dwordx4 v[100:103], v100, s[16:19], 0 offen sc1
    buffer_load_dwordx4 v[104:107], v104, s[16:19], 0 offen sc1
    buffer_load_dwordx4 v[108:111], v108, s[16:19], 0 offen sc1
M_CR3:
    s_waitcnt lgkmcnt(0)
    s_bitcmp1_b32 s64, 3
    s_cbranch_scc1 M_CH4
    v_mad_u32_u16 v112, v60, s32, v1
    v_mad_u32_u16 v116, v61, s32, v1
    v_mad_u32_u16 v120, v62, s32, v1
    v_mad_u32_u16 v124, v63, s32, v1
    buffer_load_dwordx4 v[112:115], v112, s[16:19], 0 offen sc1
    buffer_load_dwordx4 v[116:119], v116, s[16:19], 0 offen sc1
    buffer_load_dwordx4 v[120:123], v120, s[16:19], 0 offen sc1
    buffer_load_dwordx4 v[124:127], v124, s[16:19], 0 offen sc1
M_CR4:
M_PRO_DONE:
    s_cmp_eq_u32 s81, 0
    s_cbranch_scc1 M_RET2
    s_mov_b32 s82, 2
    s_mov_b32 s83, s74
    s_branch M_POSTWORK
M_RET2:
    s_and_b32 s65, s84, s72
    s_cmp_lg_u32 s65, 0
    s_cbranch_scc1 M_GO
    v_mov_b32 v32, 0
    v_mov_b32 v33, 0
    v_mov_b32 v34, 0
    v_mov_b32 v35, 0
    v_mov_b32 v36, 0
    v_mov_b32 v37, 0
    v_mov_b32 v38, 0
    v_mov_b32 v39, 0
    v_mov_b32 v40, 0
    v_mov_b32 v41, 0
    v_mov_b32 v42, 0
    v_mov_b32 v43, 0
    v_mov_b32 v44, 0
    v_mov_b32 v45, 0
    v_mov_b32 v46, 0
    v_mov_b32 v47, 0
    s_cmp_eq_u32 s34, 0
    s_cbranch_scc1 M_GO
    v_mad_u32_u16 v14, v12, s32, v1
    v_mad_u32_u16 v15, v12, s32, v1 op_sel:[1,0,0,0]
    v_lshlrev_b32 v14, 1, v14
    v_lshlrev_b32 v15, 1, v15
    s_lshl_b32 s65, s68, 1
    s_add_u32 s65, s65, 0x3000000
    s_cmp_lg_u32 s84, 0
    s_cbranch_scc1 M_LP2
    s_cmp_eq_u32 s72, 0
    s_cbranch_scc1 M_LP1
    v_mov_b32 v14, v15
    s_branch M_LP1
M_LP2:
    buffer_load_dwordx4 v[40:43], v15, s[20:23], s65 offen
    buffer_load_dwordx4 v[44:47], v15, s[20:23], s65 offen offset:16
M_LP1:
    buffer_load_dwordx4 v[32:35], v14, s[20:23], s65 offen
    buffer_load_dwordx4 v[36:39], v14, s[20:23], s65 offen offset:16
    s_waitcnt vmcnt(0)
M_GO:
    s_cmp_eq_u32 s74, 0
    s_cbranch_scc1 M_SEG_END
    s_cmp_eq_u32 s74, 1
    s_cbranch_scc1 M_DRAIN0
M_LOOP:
    s_waitcnt vmcnt(12)
    s_bitcmp1_b32 s64, 0
    s_cbranch_scc1 M_CS5
    v_perm_b32 v8, v48, v48, v7
    v_perm_b32 v9, v48, v48, v13
    v_perm_b32 v10, v49, v49, v7
    v_perm_b32 v11, v49, v49, v13
    v_mfma_f32_4x4x4_16b_bf16 v[32:35], v[64:65], v[8:9], v[32:35]
    v_mfma_f32_4x4x4_16b_bf16 v[36:39], v[66:67], v[8:9], v[36:39]
    v_perm_b32 v8, v50, v50, v7
    v_perm_b32 v9, v50, v50, v13
    v_mfma_f32_4x4x4_16b_bf16 v[32:35], v[68:69], v[10:11], v[32:35]
    v_mfma_f32_4x4x4_16b_bf16 v[36:39], v[70:71], v[10:11], v[36:39]
    v_perm_b32 v10, v51, v51, v7
    v_perm_b32 v11, v51, v51, v13
    v_mfma_f32_4x4x4_16b_bf16 v[32:35], v[72:73], v[8:9], v[32:35]
    v_mfma_f32_4x4x4_16b_bf16 v[36:39], v[74:75], v[8:9], v[36:39]
    s_nop 0
    v_mfma_f32_4x4x4_16b_bf16 v[32:35], v[76:77], v[10:11], v[32:35]
    v_mfma_f32_4x4x4_16b_bf16 v[36:39], v[78:79], v[10:11], v[36:39]
M_CS5:
    v_cmp_lt_u32 vcc, v2, v3
    v_mov_b32 v6, s70
    s_bitset0_b32 s64, 0
    v_cndmask_b32 v6, v6, v2, vcc
    s_cmp_eq_u64 vcc, 0
    s_cselect_b32 s85, 1, 0
    s_or_b32 s64, s64, s85
    v_add_u32 v2, s69, v2
    ds_read_b128 v[48:51], v6
    s_waitcnt vmcnt(8)
    s_bitcmp1_b32 s64, 1
    s_cbranch_scc1 M_CS6
    v_perm_b32 v8, v52, v52, v7
    v_perm_b32 v9, v52, v52, v13
    v_perm_b32 v10, v53, v53, v7
    v_perm_b32 v11, v53, v53, v13
    v_mfma_f32_4x4x4_16b_bf16 v[40:43], v[80:81], v[8:9], v[40:43]
    v_mfma_f32_4x4x4_16b_bf16 v[44:47], v[82:83], v[8:9], v[44:47]
    v_perm_b32 v8, v54, v54, v7
    v_perm_b32 v9, v54, v54, v13
    v_mfma_f32_4x4x4_16b_bf16 v[40:43], v[84:85], v[10:11], v[40:43]
    v_mfma_f32_4x4x4_16b_bf16 v[44:47], v[86:87], v[10:11], v[44:47]
    v_perm_b32 v10, v55, v55, v7
    v_perm_b32 v11, v55, v55, v13
    v_mfma_f32_4x4x4_16b_bf16 v[40:43], v[88:89], v[8:9], v[40:43]
    v_mfma_f32_4x4x4_16b_bf16 v[44:47], v[90:91], v[8:9], v[44:47]
    s_nop 0
    v_mfma_f32_4x4x4_16b_bf16 v[40:43], v[92:93], v[10:11], v[40:43]
    v_mfma_f32_4x4x4_16b_bf16 v[44:47], v[94:95], v[10:11], v[44:47]
M_CS6:
    v_cmp_lt_u32 s[36:37], v4, v5
    v_mov_b32 v6, s70
    s_bitset0_b32 s64, 1
    v_cndmask_b32 v6, v6, v4, s[36:37]
    s_cmp_eq_u64 s[36:37], 0
    s_cselect_b32 s85, 2, 0
    s_or_b32 s64, s64, s85
    v_add_u32 v4, s69, v4
    ds_read_b128 v[52:55], v6
    s_or_b64 s[38:39], vcc, s[36:37]
    s_cbranch_scc0 M_DRAIN1
    s_waitcnt lgkmcnt(1)
    s_bitcmp1_b32 s64, 0
    s_cbranch_scc1 M_CH7
    v_mad_u32_u16 v64, v48, s32, v1
    v_mad_u32_u16 v68, v49, s32, v1
    v_mad_u32_u16 v72, v50, s32, v1
    v_mad_u32_u16 v76, v51, s32, v1
    buffer_load_dwordx4 v[64:67], v64, s[16:19], 0 offen sc1
    buffer_load_dwordx4 v[68:71], v68, s[16:19], 0 offen sc1
    buffer_load_dwordx4 v[72:75], v72, s[16:19], 0 offen sc1
    buffer_load_dwordx4 v[76:79], v76, s[16:19], 0 offen sc1
M_CR7:
    s_waitcnt lgkmcnt(0)
    s_bitcmp1_b32 s64, 1
    s_cbranch_scc1 M_CH8
    v_mad_u32_u16 v80, v52, s32, v1
    v_mad_u32_u16 v84, v53, s32, v1
    v_mad_u32_u16 v88, v54, s32, v1
    v_mad_u32_u16 v92, v55, s32, v1
    buffer_load_dwordx4 v[80:83], v80, s[16:19], 0 offen sc1
    buffer_load_dwordx4 v[84:87], v84, s[16:19], 0 offen sc1
    buffer_load_dwordx4 v[88:91], v88, s[16:19], 0 offen sc1
    buffer_load_dwordx4 v[92:95], v92, s[16:19], 0 offen sc1
M_CR8:
    s_waitcnt vmcnt(12)
    s_bitcmp1_b32 s64, 2
    s_cbranch_scc1 M_CS9
    v_perm_b32 v8, v56, v56, v7
    v_perm_b32 v9, v56, v56, v13
    v_perm_b32 v10, v57, v57, v7
    v_perm_b32 v11, v57, v57, v13
    v_mfma_f32_4x4x4_16b_bf16 v[32:35], v[96:97], v[8:9], v[32:35]
    v_mfma_f32_4x4x4_16b_bf16 v[36:39], v[98:99], v[8:9], v[36:39]
    v_perm_b32 v8, v58, v58, v7
    v_perm_b32 v9, v58, v58, v13
    v_mfma_f32_4x4x4_16b_bf16 v[32:35], v[100:101], v[10:11], v[32:35]
    v_mfma_f32_4x4x4_16b_bf16 v[36:39], v[102:103], v[10:11], v[36:39]
    v_perm_b32 v10, v59, v59, v7
    v_perm_b32 v11, v59, v59, v13
    v_mfma_f32_4x4x4_16b_bf16 v[32:35], v[104:105], v[8:9], v[32:35]
    v_mfma_f32_4x4x4_16b_bf16 v[36:39], v[106:107], v[8:9], v[36:39]
    s_nop 0
    v_mfma_f32_4x4x4_16b_bf16 v[32:35], v[108:109], v[10:11], v[32:35]
    v_mfma_f32_4x4x4_16b_bf16 v[36:39], v[110:111], v[10:11], v[36:39]
M_CS9:
    v_cmp_lt_u32 vcc, v2, v3
    v_mov_b32 v6, s70
    s_bitset0_b32 s64, 2
    v_cndmask_b32 v6, v6, v2, vcc
    s_cmp_eq_u64 vcc, 0
    s_cselect_b32 s85, 4, 0
    s_or_b32 s64, s64, s85
    v_add_u32 v2, s69, v2
    ds_read_b128 v[56:59], v6
    s_waitcnt vmcnt(8)
    s_bitcmp1_b32 s64, 3
    s_cbranch_scc1 M_CS10
    v_perm_b32 v8, v60, v60, v7
    v_perm_b32 v9, v60, v60, v13
    v_perm_b32 v10, v61, v61, v7
    v_perm_b32 v11, v61, v61, v13
    v_mfma_f32_4x4x4_16b_bf16 v[40:43], v[112:113], v[8:9], v[40:43]
    v_mfma_f32_4x4x4_16b_bf16 v[44:47], v[114:115], v[8:9], v[44:47]
    v_perm_b32 v8, v62, v62, v7
    v_perm_b32 v9, v62, v62, v13
    v_mfma_f32_4x4x4_16b_bf16 v[40:43], v[116:117], v[10:11], v[40:43]
    v_mfma_f32_4x4x4_16b_bf16 v[44:47], v[118:119], v[10:11], v[44:47]
    v_perm_b32 v10, v63, v63, v7
    v_perm_b32 v11, v63, v63, v13
    v_mfma_f32_4x4x4_16b_bf16 v[40:43], v[120:121], v[8:9], v[40:43]
    v_mfma_f32_4x4x4_16b_bf16 v[44:47], v[122:123], v[8:9], v[44:47]
    s_nop 0
    v_mfma_f32_4x4x4_16b_bf16 v[40:43], v[124:125], v[10:11], v[40:43]
    v_mfma_f32_4x4x4_16b_bf16 v[44:47], v[126:127], v[10:11], v[44:47]
M_CS10:
    v_cmp_lt_u32 s[36:37], v4, v5
    v_mov_b32 v6, s70
    s_bitset0_b32 s64, 3
    v_cndmask_b32 v6, v6, v4, s[36:37]
    s_cmp_eq_u64 s[36:37], 0
    s_cselect_b32 s85, 8, 0
    s_or_b32 s64, s64, s85
    v_add_u32 v4, s69, v4
    ds_read_b128 v[60:63], v6
    s_or_b64 s[38:39], vcc, s[36:37]
    s_cbranch_scc0 M_DRAIN0
    s_waitcnt lgkmcnt(1)
    s_bitcmp1_b32 s64, 2
    s_cbranch_scc1 M_CH11
    v_mad_u32_u16 v96, v56, s32, v1
    v_mad_u32_u16 v100, v57, s32, v1
    v_mad_u32_u16 v104, v58, s32, v1
    v_mad_u32_u16 v108, v59, s32, v1
    buffer_load_dwordx4 v[96:99], v96, s[16:19], 0 offen sc1
    buffer_load_dwordx4 v[100:103], v100, s[16:19], 0 offen sc1
    buffer_load_dwordx4 v[104:107], v104, s[16:19], 0 offen sc1
    buffer_load_dwordx4 v[108:111], v108, s[16:19], 0 offen sc1
M_CR11:
    s_waitcnt lgkmcnt(0)
    s_bitcmp1_b32 s64, 3
    s_cbranch_scc1 M_CH12
    v_mad_u32_u16 v112, v60, s32, v1
    v_mad_u32_u16 v116, v61, s32, v1
    v_mad_u32_u16 v120, v62, s32, v1
    v_mad_u32_u16 v124, v63, s32, v1
    buffer_load_dwordx4 v[112:115], v112, s[16:19], 0 offen sc1
    buffer_load_dwordx4 v[116:119], v116, s[16:19], 0 offen sc1
    buffer_load_dwordx4 v[120:123], v120, s[16:19], 0 offen sc1
    buffer_load_dwordx4 v[124:127], v124, s[16:19], 0 offen sc1
M_CR12:
    s_branch M_LOOP
M_DRAIN1:
    s_waitcnt vmcnt(4)
    s_bitcmp1_b32 s64, 2
    s_cbranch_scc1 M_CS13
    v_perm_b32 v8, v56, v56, v7
    v_perm_b32 v9, v56, v56, v13
    v_perm_b32 v10, v57, v57, v7
    v_perm_b32 v11, v57, v57, v13
    v_mfma_f32_4x4x4_16b_bf16 v[32:35], v[96:97], v[8:9], v[32:35]
    v_mfma_f32_4x4x4_16b_bf16 v[36:39], v[98:99], v[8:9], v[36:39]
    v_perm_b32 v8, v58, v58, v7
    v_perm_b32 v9, v58, v58, v13
    v_mfma_f32_4x4x4_16b_bf16 v[32:35], v[100:101], v[10:11], v[32:35]
    v_mfma_f32_4x4x4_16b_bf16 v[36:39], v[102:103], v[10:11], v[36:39]
    v_perm_b32 v10, v59, v59, v7
    v_perm_b32 v11, v59, v59, v13
    v_mfma_f32_4x4x4_16b_bf16 v[32:35], v[104:105], v[8:9], v[32:35]
    v_mfma_f32_4x4x4_16b_bf16 v[36:39], v[106:107], v[8:9], v[36:39]
    s_nop 0
    v_mfma_f32_4x4x4_16b_bf16 v[32:35], v[108:109], v[10:11], v[32:35]
    v_mfma_f32_4x4x4_16b_bf16 v[36:39], v[110:111], v[10:11], v[36:39]
M_CS13:
    s_waitcnt vmcnt(0)
    s_bitcmp1_b32 s64, 3
    s_cbranch_scc1 M_CS14
    v_perm_b32 v8, v60, v60, v7
    v_perm_b32 v9, v60, v60, v13
    v_perm_b32 v10, v61, v61, v7
    v_perm_b32 v11, v61, v61, v13
    v_mfma_f32_4x4x4_16b_bf16 v[40:43], v[112:113], v[8:9], v[40:43]
    v_mfma_f32_4x4x4_16b_bf16 v[44:47], v[114:115], v[8:9], v[44:47]
    v_perm_b32 v8, v62, v62, v7
    v_perm_b32 v9, v62, v62, v13
    v_mfma_f32_4x4x4_16b_bf16 v[40:43], v[116:117], v[10:11], v[40:43]
    v_mfma_f32_4x4x4_16b_bf16 v[44:47], v[118:119], v[10:11], v[44:47]
    v_perm_b32 v10, v63, v63, v7
    v_perm_b32 v11, v63, v63, v13
    v_mfma_f32_4x4x4_16b_bf16 v[40:43], v[120:121], v[8:9], v[40:43]
    v_mfma_f32_4x4x4_16b_bf16 v[44:47], v[122:123], v[8:9], v[44:47]
    s_nop 0
    v_mfma_f32_4x4x4_16b_bf16 v[40:43], v[124:125], v[10:11], v[40:43]
    v_mfma_f32_4x4x4_16b_bf16 v[44:47], v[126:127], v[10:11], v[44:47]
M_CS14:
    s_branch M_SEG_END
M_DRAIN0:
    s_waitcnt vmcnt(4)
    s_bitcmp1_b32 s64, 0
    s_cbranch_scc1 M_CS15
    v_perm_b32 v8, v48, v48, v7
    v_perm_b32 v9, v48, v48, v13
    v_perm_b32 v10, v49, v49, v7
    v_perm_b32 v11, v49, v49, v13
    v_mfma_f32_4x4x4_16b_bf16 v[32:35], v[64:65], v[8:9], v[32:35]
    v_mfma_f32_4x4x4_16b_bf16 v[36:39], v[66:67], v[8:9], v[36:39]
    v_perm_b32 v8, v50, v50, v7
    v_perm_b32 v9, v50, v50, v13
    v_mfma_f32_4x4x4_16b_bf16 v[32:35], v[68:69], v[10:11], v[32:35]
    v_mfma_f32_4x4x4_16b_bf16 v[36:39], v[70:71], v[10:11], v[36:39]
    v_perm_b32 v10, v51, v51, v7
    v_perm_b32 v11, v51, v51, v13
    v_mfma_f32_4x4x4_16b_bf16 v[32:35], v[72:73], v[8:9], v[32:35]
    v_mfma_f32_4x4x4_16b_bf16 v[36:39], v[74:75], v[8:9], v[36:39]
    s_nop 0
    v_mfma_f32_4x4x4_16b_bf16 v[32:35], v[76:77], v[10:11], v[32:35]
    v_mfma_f32_4x4x4_16b_bf16 v[36:39], v[78:79], v[10:11], v[36:39]
M_CS15:
    s_waitcnt vmcnt(0)
    s_bitcmp1_b32 s64, 1
    s_cbranch_scc1 M_CS16
    v_perm_b32 v8, v52, v52, v7
    v_perm_b32 v9, v52, v52, v13
    v_perm_b32 v10, v53, v53, v7
    v_perm_b32 v11, v53, v53, v13
    v_mfma_f32_4x4x4_16b_bf16 v[40:43], v[80:81], v[8:9], v[40:43]
    v_mfma_f32_4x4x4_16b_bf16 v[44:47], v[82:83], v[8:9], v[44:47]
    v_perm_b32 v8, v54, v54, v7
    v_perm_b32 v9, v54, v54, v13
    v_mfma_f32_4x4x4_16b_bf16 v[40:43], v[84:85], v[10:11], v[40:43]
    v_mfma_f32_4x4x4_16b_bf16 v[44:47], v[86:87], v[10:11], v[44:47]
    v_perm_b32 v10, v55, v55, v7
    v_perm_b32 v11, v55, v55, v13
    v_mfma_f32_4x4x4_16b_bf16 v[40:43], v[88:89], v[8:9], v[40:43]
    v_mfma_f32_4x4x4_16b_bf16 v[44:47], v[90:91], v[8:9], v[44:47]
    s_nop 0
    v_mfma_f32_4x4x4_16b_bf16 v[40:43], v[92:93], v[10:11], v[40:43]
    v_mfma_f32_4x4x4_16b_bf16 v[44:47], v[94:95], v[10:11], v[44:47]
M_CS16:
M_SEG_END:
    s_nop 4
    s_waitcnt lgkmcnt(0)
    s_add_u32 s65, s34, 1
    s_mul_i32 s65, s65, 48
    s_cmp_ge_u32 s65, s35
    s_cselect_b32 s73, 1, 0
    s_cmp_lg_u32 s84, 0
    s_cbranch_scc1 M_END_P2
    v_add_f32 v32, v32, v40
    v_add_f32 v33, v33, v41
    v_add_f32 v34, v34, v42
    v_add_f32 v35, v35, v43
    v_add_f32 v36, v36, v44
    v_add_f32 v37, v37, v45
    v_add_f32 v38, v38, v46
    v_add_f32 v39, v39, v47
    s_cmp_eq_u32 s67, 12
    s_cselect_b32 s65, 1, 0
    s_andn2_b32 s65, s65, s72
    s_cmp_lg_u32 s65, 0
    s_cbranch_scc1 M_P1NEXT
    s_cmp_lg_u32 s73, 0
    s_cbranch_scc1 M_PUB
    v_mad_u32_u16 v14, v12, s32, v1
    v_mad_u32_u16 v15, v12, s32, v1 op_sel:[1,0,0,0]
    v_lshlrev_b32 v14, 1, v14
    v_lshlrev_b32 v15, 1, v15
    s_lshl_b32 s65, s68, 1
    s_add_u32 s65, s65, 0x3000000
    s_cmp_eq_u32 s72, 0
    s_cbranch_scc1 M_SP1
    v_mov_b32 v14, v15
M_SP1:
    buffer_store_dwordx4 v[32:35], v14, s[20:23], s65 offen
    buffer_store_dwordx4 v[36:39], v14, s[20:23], s65 offen offset:16
    s_waitcnt vmcnt(0)
    s_branch M_P1NEXT
M_PUB:
    s_cmp_lg_u32 s72, 0
    s_cbranch_scc1 M_PUBB
    v_cvt_pk_bf16_f32 v24, v32, v33
    v_cvt_pk_bf16_f32 v25, v34, v35
    v_cvt_pk_bf16_f32 v26, v36, v37
    v_cvt_pk_bf16_f32 v27, v38, v39
    v_mad_u32_u16 v14, v12, s32, v1
    v_add_u32 v14, s68, v14
    buffer_store_dwordx4 v[24:27], v14, s[76:79], 0 offen sc1
    buffer_load_dwordx4 v[16:19], v14, s[28:31], 0 offen
    s_branch M_SIG
M_PUBB:
    v_cvt_pk_bf16_f32 v28, v32, v33
    v_cvt_pk_bf16_f32 v29, v34, v35
    v_cvt_pk_bf16_f32 v30, v36, v37
    v_cvt_pk_bf16_f32 v31, v38, v39
    v_mad_u32_u16 v14, v12, s32, v1 op_sel:[1,0,0,0]
    v_add_u32 v14, s68, v14
    buffer_store_dwordx4 v[28:31], v14, s[76:79], 0 offen sc1
    buffer_load_dwordx4 v[20:23], v14, s[28:31], 0 offen
M_SIG:
    s_add_u32 s81, s72, 1
    s_mov_b32 s82, 4
    s_mov_b32 s83, 0
    s_branch M_POSTWORK
M_P1NEXT:
    s_cmp_lg_u32 s72, 0
    s_cbranch_scc1 M_P1DONE
    s_mov_b32 s72, 1
    s_branch M_SEG
M_P1DONE:
    s_cmp_lg_u32 s73, 0
    s_cbranch_scc1 M_TOP2
M_NEXTROUND:
    s_add_u32 s34, s34, 1
    s_waitcnt vmcnt(0) lgkmcnt(0)
    s_barrier
    s_branch M_ROUND
M_TOP2:
    s_mov_b32 s16, s76
    s_mov_b32 s17, s77
    s_mov_b32 s18, s78
    s_mov_b32 s19, s79
    s_mov_b32 s84, 1
    s_mov_b32 s34, 0
    s_mov_b32 s72, 0
    s_cmp_eq_u32 s35, 0
    s_cbranch_scc1 M_SEG
    s_mov_b32 s82, 3
    s_mov_b32 s83, 0
    s_branch M_POSTWORK
M_RET3:
    s_waitcnt lgkmcnt(0)
    s_barrier
    s_branch M_ROUND
M_POSTWORK:
    s_cmp_eq_u32 s81, 3
    s_cbranch_scc1 M_PGEMM
    s_sub_u32 s81, s81, 1
    v_mov_b32 v33, 1
    s_lshl_b32 s65, s81, 2
    s_add_u32 s65, s65, 5792
    v_mov_b32 v34, s65
    s_lshl_b32 s66, s81, 13
    s_add_u32 s66, s66, 0xa00000
    s_and_b32 s85, s2, 15
    s_lshl_b32 s65, s85, 7
    s_add_u32 s38, s65, s66
    s_cmp_lt_u32 s85, 10
    s_cselect_b32 s85, 15, 14
    v_and_b32 v36, 31, v0
    v_lshlrev_b32 v36, 7, v36
    s_waitcnt vmcnt(1)
    s_mov_b64 exec, 1
    ds_add_rtn_u32 v35, v34, v33
    s_waitcnt lgkmcnt(0)
    v_readfirstlane_b32 s65, v35
    s_sub_u32 s65, s65, s81
    s_cmp_lg_u32 s65, 11
    s_cbranch_scc1 M_NOSIG
    s_mov_b32 s65, 1
    s_atomic_add s65, s[12:13], s38 glc
    s_waitcnt lgkmcnt(0)
    s_cmp_lg_u32 s65, s85
    s_cbranch_scc1 M_NOSIG
    s_mov_b32 exec_lo, -1
    buffer_atomic_add v33, v36, s[20:23], s66 offen offset:2048
    s_nop 1
M_NOSIG:
    s_mov_b64 exec, -1
    s_mul_i32 s81, s81, 3
    s_branch M_P1NEXT
M_PGEMM:
    s_mov_b32 s81, 0
    s_mul_i32 s65, s67, 4352
    s_add_u32 s65, s65, 84992
    v_bfe_u32 v14, v0, 3, 3
    v_mad_u32_u24 v14, v14, s71, v1
    v_add_u32 v14, s65, v14
    v_and_b32 v6, 15, v0
    v_bfe_u32 v15, v0, 4, 2
    v_lshlrev_b32 v15, 4, v15
    v_mad_u32_u24 v15, v6, s71, v15
    v_add_u32 v15, s65, v15
    v_and_b32 v6, 63, v0
    v_lshlrev_b32 v6, 4, v6
    v_add_u32 v6, 60416, v6
    ds_write_b128 v14, v[24:27] offset:128
    ds_write_b128 v14, v[28:31] offset:2304
    s_waitcnt vmcnt(17)
    s_cmp_eq_u32 s83, 3
    s_cbranch_scc1 M_W16b
    s_cmp_eq_u32 s83, 1
    s_cbranch_scc1 M_W8b
    s_waitcnt vmcnt(0)
M_W8b:
    s_waitcnt vmcnt(8)
M_W16b:
    s_waitcnt vmcnt(16)
    ds_write_b128 v14, v[16:19]
    ds_write_b128 v14, v[20:23] offset:2176
    s_waitcnt lgkmcnt(0)
    v_mov_b32 v16, 0
    v_mov_b32 v17, 0
    v_mov_b32 v18, 0
    v_mov_b32 v19, 0
    v_mov_b32 v20, 0
    v_mov_b32 v21, 0
    v_mov_b32 v22, 0
    v_mov_b32 v23, 0
    v_mov_b32 v24, 0
    v_mov_b32 v25, 0
    v_mov_b32 v26, 0
    v_mov_b32 v27, 0
    v_mov_b32 v28, 0
    v_mov_b32 v29, 0
    v_mov_b32 v30, 0
    v_mov_b32 v31, 0
    ds_read_b128 v[32:35], v15 offset:0
    ds_read_b128 v[36:39], v6 offset:0
    ds_read_b128 v[40:43], v6 offset:1024
    ds_read_b128 v[44:47], v6 offset:2048
    s_waitcnt lgkmcnt(2)
    v_mfma_f32_16x16x32_bf16 v[16:19], v[36:39], v[32:35], v[16:19]
    ds_read_b128 v[36:39], v6 offset:3072
    s_waitcnt lgkmcnt(2)
    v_mfma_f32_16x16x32_bf16 v[20:23], v[40:43], v[32:35], v[20:23]
    s_waitcnt lgkmcnt(1)
    v_mfma_f32_16x16x32_bf16 v[24:27], v[44:47], v[32:35], v[24:27]
    s_waitcnt lgkmcnt(0)
    v_mfma_f32_16x16x32_bf16 v[28:31], v[36:39], v[32:35], v[28:31]
    ds_read_b128 v[32:35], v15 offset:64
    ds_read_b128 v[36:39], v6 offset:4096
    ds_read_b128 v[40:43], v6 offset:5120
    ds_read_b128 v[44:47], v6 offset:6144
    s_waitcnt lgkmcnt(2)
    v_mfma_f32_16x16x32_bf16 v[16:19], v[36:39], v[32:35], v[16:19]
    ds_read_b128 v[36:39], v6 offset:7168
    s_waitcnt lgkmcnt(2)
    v_mfma_f32_16x16x32_bf16 v[20:23], v[40:43], v[32:35], v[20:23]
    s_waitcnt lgkmcnt(1)
    v_mfma_f32_16x16x32_bf16 v[24:27], v[44:47], v[32:35], v[24:27]
    s_waitcnt lgkmcnt(0)
    v_mfma_f32_16x16x32_bf16 v[28:31], v[36:39], v[32:35], v[28:31]
    ds_read_b128 v[32:35], v15 offset:128
    ds_read_b128 v[36:39], v6 offset:8192
    ds_read_b128 v[40:43], v6 offset:9216
    ds_read_b128 v[44:47], v6 offset:10240
    s_waitcnt lgkmcnt(2)
    v_mfma_f32_16x16x32_bf16 v[16:19], v[36:39], v[32:35], v[16:19]
    ds_read_b128 v[36:39], v6 offset:11264
    s_waitcnt lgkmcnt(2)
    v_mfma_f32_16x16x32_bf16 v[20:23], v[40:43], v[32:35], v[20:23]
    s_waitcnt lgkmcnt(1)
    v_mfma_f32_16x16x32_bf16 v[24:27], v[44:47], v[32:35], v[24:27]
    s_waitcnt lgkmcnt(0)
    v_mfma_f32_16x16x32_bf16 v[28:31], v[36:39], v[32:35], v[28:31]
    ds_read_b128 v[32:35], v15 offset:192
    ds_read_b128 v[36:39], v6 offset:12288
    ds_read_b128 v[40:43], v6 offset:13312
    ds_read_b128 v[44:47], v6 offset:14336
    s_waitcnt lgkmcnt(2)
    v_mfma_f32_16x16x32_bf16 v[16:19], v[36:39], v[32:35], v[16:19]
    ds_read_b128 v[36:39], v6 offset:15360
    s_waitcnt lgkmcnt(2)
    v_mfma_f32_16x16x32_bf16 v[20:23], v[40:43], v[32:35], v[20:23]
    s_waitcnt lgkmcnt(1)
    v_mfma_f32_16x16x32_bf16 v[24:27], v[44:47], v[32:35], v[24:27]
    s_waitcnt lgkmcnt(0)
    v_mfma_f32_16x16x32_bf16 v[28:31], v[36:39], v[32:35], v[28:31]
M_POSTEND:
    s_cmp_eq_u32 s82, 2
    s_cbranch_scc1 M_RET2
    s_cmp_eq_u32 s82, 1
    s_cbranch_scc1 M_RET1
    s_cmp_eq_u32 s82, 4
    s_cbranch_scc1 M_P1NEXT
    s_branch M_RET3
M_END_P2:
    s_cmp_lg_u32 s72, 0
    s_cbranch_scc1 M_P2DONE
    s_mov_b32 s72, 1
    s_branch M_SEG
M_P2DONE:
    s_cmp_lg_u32 s73, 0
    s_cbranch_scc1 M_FINAL2
    v_mad_u32_u16 v14, v12, s32, v1
    v_mad_u32_u16 v15, v12, s32, v1 op_sel:[1,0,0,0]
    v_lshlrev_b32 v14, 1, v14
    v_lshlrev_b32 v15, 1, v15
    s_lshl_b32 s65, s68, 1
    s_add_u32 s65, s65, 0x3000000
    buffer_store_dwordx4 v[40:43], v15, s[20:23], s65 offen
    buffer_store_dwordx4 v[44:47], v15, s[20:23], s65 offen offset:16
    s_cmp_eq_u32 s67, 12
    s_cbranch_scc1 M_NEXTROUND
    buffer_store_dwordx4 v[32:35], v14, s[20:23], s65 offen
    buffer_store_dwordx4 v[36:39], v14, s[20:23], s65 offen offset:16
    s_branch M_NEXTROUND
M_FINAL2:
    s_mul_i32 s65, s67, 4352
    s_add_u32 s65, s65, 84992
    v_bfe_u32 v14, v0, 3, 3
    v_mad_u32_u24 v14, v14, s71, v1
    v_add_u32 v14, s65, v14
    v_and_b32 v94, 15, v0
    v_bfe_u32 v15, v0, 4, 2
    v_lshlrev_b32 v15, 4, v15
    v_mad_u32_u24 v15, v94, s71, v15
    v_add_u32 v15, s65, v15
    v_and_b32 v94, 63, v0
    v_lshlrev_b32 v94, 4, v94
    v_add_u32 v94, 60416, v94
    ds_read_b128 v[64:67], v14
    ds_read_b128 v[68:71], v14 offset:2176
    v_and_b32 v93, 7, v0
    v_lshl_add_u32 v93, v93, 3, s75
    v_bfe_u32 v92, v0, 3, 1
    v_mul_u32_u24 v92, 832, v92
    v_add_u32 v93, v93, v92
    ds_read_b32 v93, v93
    ds_read_b128 v[96:99], v94 offset:16384
    ds_read_b128 v[100:103], v94 offset:17408
    ds_read_b128 v[104:107], v94 offset:18432
    ds_read_b128 v[108:111], v94 offset:19456
    ds_read_b128 v[112:115], v94 offset:20480
    ds_read_b128 v[116:119], v94 offset:21504
    ds_read_b128 v[120:123], v94 offset:22528
    ds_read_b128 v[124:127], v94 offset:23552
    s_waitcnt lgkmcnt(9)
    v_lshlrev_b32 v88, 16, v64
    v_and_b32 v89, s33, v64
    v_fma_f32 v88, 2.0, v32, -v88
    v_fma_f32 v89, 2.0, v33, -v89
    v_cvt_pk_bf16_f32 v80, v88, v89
    v_lshlrev_b32 v88, 16, v65
    v_and_b32 v89, s33, v65
    v_fma_f32 v88, 2.0, v34, -v88
    v_fma_f32 v89, 2.0, v35, -v89
    v_cvt_pk_bf16_f32 v81, v88, v89
    v_lshlrev_b32 v88, 16, v66
    v_and_b32 v89, s33, v66
    v_fma_f32 v88, 2.0, v36, -v88
    v_fma_f32 v89, 2.0, v37, -v89
    v_cvt_pk_bf16_f32 v82, v88, v89
    v_lshlrev_b32 v88, 16, v67
    v_and_b32 v89, s33, v67
    v_fma_f32 v88, 2.0, v38, -v88
    v_fma_f32 v89, 2.0, v39, -v89
    v_cvt_pk_bf16_f32 v83, v88, v89
    v_lshlrev_b32 v88, 16, v68
    v_and_b32 v89, s33, v68
    v_fma_f32 v88, 2.0, v40, -v88
    v_fma_f32 v89, 2.0, v41, -v89
    v_cvt_pk_bf16_f32 v84, v88, v89
    v_lshlrev_b32 v88, 16, v69
    v_and_b32 v89, s33, v69
    v_fma_f32 v88, 2.0, v42, -v88
    v_fma_f32 v89, 2.0, v43, -v89
    v_cvt_pk_bf16_f32 v85, v88, v89
    v_lshlrev_b32 v88, 16, v70
    v_and_b32 v89, s33, v70
    v_fma_f32 v88, 2.0, v44, -v88
    v_fma_f32 v89, 2.0, v45, -v89
    v_cvt_pk_bf16_f32 v86, v88, v89
    v_lshlrev_b32 v88, 16, v71
    v_and_b32 v89, s33, v71
    v_fma_f32 v88, 2.0, v46, -v88
    v_fma_f32 v89, 2.0, v47, -v89
    v_cvt_pk_bf16_f32 v87, v88, v89
    ds_write_b128 v14, v[80:83] offset:128
    ds_write_b128 v14, v[84:87] offset:2304
    ds_read_b128 v[72:75], v15 offset:128
    ds_read_b128 v[76:79], v15 offset:192
    s_waitcnt lgkmcnt(1)
    v_mfma_f32_16x16x32_bf16 v[16:19], v[96:99], v[72:75], v[16:19]
    v_mfma_f32_16x16x32_bf16 v[20:23], v[100:103], v[72:75], v[20:23]
    v_mfma_f32_16x16x32_bf16 v[24:27], v[104:107], v[72:75], v[24:27]
    v_mfma_f32_16x16x32_bf16 v[28:31], v[108:111], v[72:75], v[28:31]
    s_waitcnt lgkmcnt(0)
    v_mfma_f32_16x16x32_bf16 v[16:19], v[112:115], v[76:79], v[16:19]
    v_mfma_f32_16x16x32_bf16 v[20:23], v[116:119], v[76:79], v[20:23]
    v_mfma_f32_16x16x32_bf16 v[24:27], v[120:123], v[76:79], v[24:27]
    v_mfma_f32_16x16x32_bf16 v[28:31], v[124:127], v[76:79], v[28:31]
    v_bfe_u32 v92, v0, 4, 2
    v_lshl_add_u32 v15, v92, 4, v15
    v_mad_u32_u16 v90, v12, s32, v1
    v_mad_u32_u16 v91, v12, s32, v1 op_sel:[1,0,0,0]
    v_add_u32 v90, s68, v90
    v_add_u32 v91, s68, v91
    s_nop 3
    v_cvt_pk_bf16_f32 v64, v16, v17
    v_cvt_pk_bf16_f32 v65, v18, v19
    v_cvt_pk_bf16_f32 v66, v20, v21
    v_cvt_pk_bf16_f32 v67, v22, v23
    v_cvt_pk_bf16_f32 v68, v24, v25
    v_cvt_pk_bf16_f32 v69, v26, v27
    v_cvt_pk_bf16_f32 v70, v28, v29
    v_cvt_pk_bf16_f32 v71, v30, v31
    ds_write_b128 v15, v[64:67]
    ds_write_b128 v15, v[68:71] offset:16
    ds_read_b128 v[72:75], v14
    ds_read_b128 v[76:79], v14 offset:2176
    s_waitcnt lgkmcnt(0)
    buffer_store_dwordx4 v[76:79], v91, s[24:27], 0 offen nt
    s_cmp_eq_u32 s67, 12
    s_cbranch_scc1 M_END
    buffer_store_dwordx4 v[72:75], v90, s[24:27], 0 offen nt
M_END:
M_END2:
    s_endpgm
M_CH1:
    s_mov_b64 exec, 1
    buffer_load_dword v64, v7, s[16:19], 0 offen
    buffer_load_dword v68, v7, s[16:19], 0 offen
    buffer_load_dword v72, v7, s[16:19], 0 offen
    buffer_load_dword v76, v7, s[16:19], 0 offen
    s_mov_b64 exec, -1
    s_branch M_CR1
M_CH2:
    s_mov_b64 exec, 1
    buffer_load_dword v80, v7, s[16:19], 0 offen
    buffer_load_dword v84, v7, s[16:19], 0 offen
    buffer_load_dword v88, v7, s[16:19], 0 offen
    buffer_load_dword v92, v7, s[16:19], 0 offen
    s_mov_b64 exec, -1
    s_branch M_CR2
M_CH3:
    s_mov_b64 exec, 1
    buffer_load_dword v96, v7, s[16:19], 0 offen
    buffer_load_dword v100, v7, s[16:19], 0 offen
    buffer_load_dword v104, v7, s[16:19], 0 offen
    buffer_load_dword v108, v7, s[16:19], 0 offen
    s_mov_b64 exec, -1
    s_branch M_CR3
M_CH4:
    s_mov_b64 exec, 1
    buffer_load_dword v112, v7, s[16:19], 0 offen
    buffer_load_dword v116, v7, s[16:19], 0 offen
    buffer_load_dword v120, v7, s[16:19], 0 offen
    buffer_load_dword v124, v7, s[16:19], 0 offen
    s_mov_b64 exec, -1
    s_branch M_CR4
M_CH7:
    s_mov_b64 exec, 1
    buffer_load_dword v64, v7, s[16:19], 0 offen
    buffer_load_dword v68, v7, s[16:19], 0 offen
    buffer_load_dword v72, v7, s[16:19], 0 offen
    buffer_load_dword v76, v7, s[16:19], 0 offen
    s_mov_b64 exec, -1
    s_branch M_CR7
M_CH8:
    s_mov_b64 exec, 1
    buffer_load_dword v80, v7, s[16:19], 0 offen
    buffer_load_dword v84, v7, s[16:19], 0 offen
    buffer_load_dword v88, v7, s[16:19], 0 offen
    buffer_load_dword v92, v7, s[16:19], 0 offen
    s_mov_b64 exec, -1
    s_branch M_CR8
M_CH11:
    s_mov_b64 exec, 1
    buffer_load_dword v96, v7, s[16:19], 0 offen
    buffer_load_dword v100, v7, s[16:19], 0 offen
    buffer_load_dword v104, v7, s[16:19], 0 offen
    buffer_load_dword v108, v7, s[16:19], 0 offen
    s_mov_b64 exec, -1
    s_branch M_CR11
M_CH12:
    s_mov_b64 exec, 1
    buffer_load_dword v112, v7, s[16:19], 0 offen
    buffer_load_dword v116, v7, s[16:19], 0 offen
    buffer_load_dword v120, v7, s[16:19], 0 offen
    buffer_load_dword v124, v7, s[16:19], 0 offen
    s_mov_b64 exec, -1
    s_branch M_CR12
M_CODE_END:
.section .rodata,"a"
.p2align 6
.amdhsa_kernel part_kernel
  .amdhsa_next_free_vgpr 64
  .amdhsa_next_free_sgpr 72
  .amdhsa_accum_offset 64
  .amdhsa_group_segment_fixed_size 0
  .amdhsa_kernarg_size 64
  .amdhsa_user_sgpr_count 2
  .amdhsa_user_sgpr_kernarg_segment_ptr 1
  .amdhsa_system_sgpr_workgroup_id_x 1
.end_amdhsa_kernel
.p2align 6
.amdhsa_kernel main_kernel
  .amdhsa_next_free_vgpr 128
  .amdhsa_next_free_sgpr 88
  .amdhsa_accum_offset 128
  .amdhsa_group_segment_fixed_size 0
  .amdhsa_kernarg_size 64
  .amdhsa_user_sgpr_count 2
  .amdhsa_user_sgpr_kernarg_segment_ptr 1
  .amdhsa_system_sgpr_workgroup_id_x 1
.end_amdhsa_kernel
```
